```python
import torch

def _softmax(x, axis=-1):
    return torch.softmax(x, dim=axis)
def _gelu(x):
    return torch.nn.functional.gelu(x, approximate="tanh")
def _silu(x):
    return torch.nn.functional.silu(x)
def _sigmoid(x):
    return torch.sigmoid(x)
def _layernorm(x, axis=-1, eps=1e-5):
    m = x.mean(dim=axis, keepdim=True)
    v = x.var(dim=axis, keepdim=True, unbiased=False)
    return (x - m) / torch.sqrt(v + eps)
def _scatter_add(tgt, idx, src, axis=0):
    return tgt.clone().index_add_(axis, idx, src)
def _segment_sum(src, seg, n):
    out = torch.zeros((n,) + src.shape[1:], dtype=src.dtype)
    return out.index_add_(0, seg, src)
def _pad(x, pw):
    flat = tuple(v for pair in reversed(pw) for v in pair)
    return torch.nn.functional.pad(x, flat)

kernel_name = 'parallel_sum__sliding_block_cached__glu_gated_geglu__decode'

def setup_inputs():

    _w = (lambda a: (lambda t: t.to(torch.bfloat16) if t.is_floating_point() else t)(torch.as_tensor(a)))
    def _A_setup():
        B, Sq, D = 1, 1, 512
        Hq, Hkv, Sk, Dh = 32, 8, 32768, 128
        assert Hq % Hkv == 0, (Hq, Hkv)
        return {
            "x": _w((lambda *s: torch.randn(*s, dtype=torch.bfloat16) * 0.05)(B, Sq, D)),
            "k_cache": _w((lambda *s: torch.randn(*s, dtype=torch.bfloat16) * 1.6)(B, Hkv, Sk, Dh)),
            "v_cache": _w((lambda *s: torch.randn(*s, dtype=torch.bfloat16) * 0.8)(B, Hkv, Sk, Dh)),
            "wq": _w((lambda *s: torch.randn(*s, dtype=torch.bfloat16) * 1.6)(D, Hq * Dh) * (D ** -0.5)),
            "wo": _w((lambda *s: torch.randn(*s, dtype=torch.bfloat16) * 0.8)(Hq * Dh, D) * ((Hq * Dh) ** -0.5)),
        }
    _A_in = _A_setup()

    def _B_setup():
        B, S, Dm, Df = 1, 1, 512, 1792
        return {
            "x": _w((lambda *s: torch.randn(*s, dtype=torch.bfloat16) * 0.05)(B, S, Dm)),
            "w_gate": _w((lambda *s: torch.randn(*s, dtype=torch.bfloat16) * 0.8)(Dm, Df) * (Dm ** -0.5)),
            "w_up": _w((lambda *s: torch.randn(*s, dtype=torch.bfloat16) * 0.8)(Dm, Df) * (Dm ** -0.5)),
            "w_down": _w((lambda *s: torch.randn(*s, dtype=torch.bfloat16) * 0.8)(Df, Dm) * (Df ** -0.5)),
        }
    _B_in = _B_setup()

    return {
        "A_x": _A_in["x"],
        "A_k_cache": _A_in["k_cache"],
        "A_v_cache": _A_in["v_cache"],
        "A_wq": _A_in["wq"],
        "A_wo": _A_in["wo"],
        "B_x": _B_in["x"],
        "B_w_gate": _B_in["w_gate"],
        "B_w_up": _B_in["w_up"],
        "B_w_down": _B_in["w_down"],
    }

def reference(A_x, A_k_cache, A_v_cache, A_wq, A_wo, B_x, B_w_gate, B_w_up, B_w_down):
    def _A_ref(x, k_cache, v_cache, wq, wo):
        B, Sq, D = x.shape
        Hq, Dh = 32, 128
        Hkv, Sk = k_cache.shape[1], k_cache.shape[2]
        W = min(4096, max(256, Sk // 4))
        rep = Hq // Hkv
        q = (lambda x, *d: x.permute(*d))((x @ wq).reshape(B, Sq, Hq, Dh), 0, 2, 1, 3)
        k = (lambda x, n, axis: torch.repeat_interleave(x, n, dim=axis))(k_cache[:, :, Sk - W:, :], rep, axis=1)
        v = (lambda x, n, axis: torch.repeat_interleave(x, n, dim=axis))(v_cache[:, :, Sk - W:, :], rep, axis=1)
        scores = torch.einsum("bhqd,bhkd->bhqk", q, k) * (Dh ** -0.5)
        p = _softmax(scores, axis=-1)
        o = torch.einsum("bhqk,bhkd->bhqd", p, v)
        return (lambda x, *d: x.permute(*d))(o, 0, 2, 1, 3).reshape(B, Sq, Hq * Dh) @ wo

    def _B_ref(x, w_gate, w_up, w_down):
        g = torch.einsum("bsd,df->bsf", x, w_gate)
        u = torch.einsum("bsd,df->bsf", x, w_up)
        h = _gelu(g) * u
        return torch.einsum("bsf,fd->bsd", h, w_down)

    x = A_x
    xn = _layernorm(x, axis=-1)
    return x + _A_ref(xn, A_k_cache, A_v_cache, A_wq, A_wo) + _B_ref(xn, B_w_gate, B_w_up, B_w_down)
```

```asm
; @launch grid=(256,1,1) block=(384,1,1) lds=128256
.amdgcn_target "amdgcn-amd-amdhsa--gfx950"
.text
.globl parallel_sum__sliding_block_cached__glu_gated_geglu__decode_kernel
.p2align 8
.type parallel_sum__sliding_block_cached__glu_gated_geglu__decode_kernel,@function
parallel_sum__sliding_block_cached__glu_gated_geglu__decode_kernel:
    v_readfirstlane_b32 s30, v0
    s_cmpk_ge_u32 s2, 256
    s_cbranch_scc1 L_end
    s_lshr_b32 s30, s30, 6
    s_cbranch_scc0 L_load
    v_lshlrev_b32 v1, 2, v0
    v_mov_b32 v2, 0
    ds_write_b32 v1, v2
    s_waitcnt lgkmcnt(0)
    s_barrier
    s_cmp_eq_u32 s30, 5
    s_cbranch_scc1 L_aux
    s_mov_b64 exec, 0
    s_cmp_eq_u32 s30, 2
    s_cbranch_scc1 L_padA
    s_cmp_eq_u32 s30, 3
    s_cbranch_scc1 L_padC
    s_cmp_eq_u32 s30, 4
    s_cbranch_scc1 L_padD
    s_branch L_comp
L_load:
    s_load_dwordx16 s[4:19], s[0:1], 0
    s_load_dwordx8 s[20:27], s[0:1], 64
    s_getpc_b64 s[34:35]
L_pc:
    v_lshlrev_b32 v2, 7, v0
    global_load_dword v28, v2, s[34:35]
    s_setprio 3
    s_and_b32 s28, s2, 7
    s_lshr_b32 s29, s2, 3
    s_lshr_b32 s48, s29, 2
    s_and_b32 s49, s29, 3
    v_lshlrev_b32 v1, 4, v0
    v_lshrrev_b32 v3, 3, v0
    v_and_b32 v4, 6, v3
    v_xor_b32 v4, v4, v0
    v_and_b32 v4, 7, v4
    v_lshlrev_b32 v4, 4, v4
    s_lshl3_add_u32 s35, s28, s48
    s_lshl_b32 s36, s35, 7
    s_lshl_b32 s37, s49, 20
    s_add_u32 s36, s36, s37
    v_lshl_add_u32 v2, v3, 13, s36
    v_add_u32 v2, v2, v4
    s_movk_i32 m0, 4352
    s_barrier
    s_waitcnt lgkmcnt(0)
    global_load_lds_dwordx4 v1, s[4:5]
    s_load_dword s31, s[26:27], 0
L_lwq:
    s_addk_i32 m0, 1024
    s_cmpk_lt_u32 m0, 20736
    global_load_lds_dwordx4 v2, s[10:11] nt
    v_add_u32 v2, 0x10000, v2
    s_cbranch_scc1 L_lwq
    v_mov_b32 v7, 0
    v_lshrrev_b32 v5, 4, v0
    v_mov_b32 v6, -7
    s_lshl_b32 s34, s28, 23
    s_lshl_b32 s39, s29, 12
    s_add_u32 s34, s34, 0x700000
L_padA:
    s_cbranch_execz L_comp
    v_lshlrev_b32 v18, 2, v0
    s_cmp_eq_u32 s28, 0
    s_cbranch_scc1 L_skgu
    s_mov_b32 m0, 21760
    s_lshr_b32 s32, s29, 3
    s_and_b32 s33, s29, 7
    s_lshl2_add_u32 s36, s28, s32
    s_sub_u32 s36, s36, 4
    s_lshl_b32 s36, s36, 7
    s_mul_i32 s37, s33, 229376
    s_add_u32 s36, s36, s37
    v_mul_u32_u24 v2, 3584, v3
    v_add3_u32 v2, v2, v4, s36
    s_sub_u32 s18, s18, 1024
    s_subb_u32 s19, s19, 0
L_lgu:
    v_add_u32 v8, 26624, v2
    global_load_lds_dwordx4 v2, s[16:17] offset:0 nt
    global_load_lds_dwordx4 v2, s[18:19] offset:1024 nt
    v_add_u32 v6, 4, v6
    s_waitcnt vmcnt(22)
    ds_write_b32 v18, v6 offset:276
    global_load_lds_dwordx4 v8, s[16:17] offset:2048 nt
    global_load_lds_dwordx4 v8, s[18:19] offset:3072 nt
    s_waitcnt vmcnt(22)
    s_addk_i32 m0, 4096
    v_add_u32 v2, 57344, v2
    s_cmpk_lt_u32 m0, 38144
    s_cbranch_scc1 L_lgu
L_skgu:
    s_mov_b32 m0, 62720
    v_xor_b32 v8, v5, v0
    v_lshl_add_u32 v8, v8, 4, s34
    v_xor_b32 v9, 64, v8
    v_xor_b32 v10, 128, v8
    v_xor_b32 v11, 192, v8
    s_mov_b32 s37, 0
L_lK:
    s_xor_b32 s36, s37, s39
    s_add_u32 s10, s6, s36
    s_addc_u32 s11, s7, 0
    s_add_u32 s37, s37, 0x21000
    global_load_lds_dwordx4 v8, s[10:11] offset:0 nt
    global_load_lds_dwordx4 v9, s[10:11] offset:1024 nt
    v_add_u32 v6, 4, v6
    s_waitcnt vmcnt(22)
    ds_write_b32 v18, v6 offset:276
    global_load_lds_dwordx4 v10, s[10:11] offset:2048 nt
    global_load_lds_dwordx4 v11, s[10:11] offset:3072 nt
    s_waitcnt vmcnt(22)
    s_addk_i32 m0, 4096
    s_bitcmp0_b32 s37, 20
    s_cbranch_scc1 L_lK
    v_lshlrev_b32 v13, 5, v5
    v_xor_b32 v13, v13, v1
    v_and_b32 v29, 0xf0, v13
    v_lshl_add_u32 v29, v5, 12, v29
    s_lshl_b32 s38, s49, 8
    s_mov_b32 m0, 95488
    v_add_u32 v8, s34, v13
    v_xor_b32 v9, 128, v8
    s_mov_b32 s37, 0
L_lV:
    s_xor_b32 s36, s37, s39
    s_add_u32 s10, s8, s36
    s_addc_u32 s11, s9, 0
    s_add_u32 s37, s37, 0x21000
    global_load_lds_dwordx4 v8, s[10:11] offset:0 nt
    global_load_lds_dwordx4 v9, s[10:11] offset:1024 nt
    v_add_u32 v6, 4, v6
    s_waitcnt vmcnt(22)
    ds_write_b32 v18, v6 offset:276
    global_load_lds_dwordx4 v8, s[10:11] offset:2048 nt
    global_load_lds_dwordx4 v9, s[10:11] offset:3072 nt
    s_waitcnt vmcnt(22)
    s_addk_i32 m0, 4096
    s_bitcmp0_b32 s37, 20
    s_cbranch_scc1 L_lV
    s_cmp_eq_u32 s28, 0
    s_cbranch_scc1 L_skdn
    s_mov_b32 m0, 38144
    s_sub_u32 s36, s35, 8
    s_lshl_b32 s36, s36, 15
    s_add_u32 s36, s36, s38
    v_add_u32 v2, s36, v29
L_ldn:
    global_load_lds_dwordx4 v2, s[20:21] offset:0 nt
    global_load_lds_dwordx4 v2, s[20:21] offset:1024 nt
    v_add_u32 v6, 4, v6
    s_waitcnt vmcnt(22)
    ds_write_b32 v18, v6 offset:276
    global_load_lds_dwordx4 v2, s[20:21] offset:2048 nt
    global_load_lds_dwordx4 v2, s[20:21] offset:3072 nt
    s_waitcnt vmcnt(22)
    s_addk_i32 m0, 4096
    v_add_u32 v2, 0x4000, v2
    s_cmpk_lt_u32 m0, 46336
    s_cbranch_scc1 L_ldn
L_skdn:
    s_mov_b32 m0, 46336
    s_lshl_b32 s36, s35, 16
    s_add_u32 s36, s36, s38
    v_add_u32 v2, s36, v29
L_lwa:
    global_load_lds_dwordx4 v2, s[12:13] offset:0 nt
    global_load_lds_dwordx4 v2, s[12:13] offset:1024 nt
    v_add_u32 v6, 4, v6
    s_waitcnt vmcnt(22)
    ds_write_b32 v18, v6 offset:276
    global_load_lds_dwordx4 v2, s[12:13] offset:2048 nt
    global_load_lds_dwordx4 v2, s[12:13] offset:3072 nt
    s_waitcnt vmcnt(22)
    s_addk_i32 m0, 4096
    v_add_u32 v2, 0x4000, v2
    s_cmpk_lt_u32 m0, 62720
    s_cbranch_scc1 L_lwa
    s_mov_b32 s44, 0x0c0c0400
    s_mov_b32 s45, 0x04000c0c
    s_mov_b32 s46, 0xffffff00
    s_lshl4_add_u32 s36, s28, s29
    s_lshl_b32 s37, s36, 3
    v_lshl_add_u32 v15, v5, 1, s37
    v_and_b32 v30, 12, v18
    s_waitcnt lgkmcnt(0)
    s_add_u32 s31, s31, 0x3b5d7f29
    v_mov_b32 v12, s31
    v_add_u32 v6, 8, v6
    s_waitcnt vmcnt(16)
    ds_write_b32 v18, v6 offset:276
    v_add_u32 v6, 8, v6
    s_waitcnt vmcnt(8)
    ds_write_b32 v18, v6 offset:276
    v_add_u32 v6, 8, v6
    s_waitcnt vmcnt(0)
    ds_write_b32 v18, v6 offset:276
    s_cmpk_lt_u32 s2, 128
    s_cbranch_scc0 L_lfin
    ds_read_u16 v16, v15 offset:4352
    s_lshr_b32 s37, s36, 5
    s_lshl_b32 s37, s37, 15
    s_and_b32 s36, s36, 31
    s_lshl4_add_u32 s37, s36, s37
    s_add_u32 s37, s37, 0x190000
    v_lshl_add_u32 v14, v1, 5, s37
    s_mov_b32 s52, 0x00010001
    s_mov_b32 s53, 0x00010001
    s_setprio 0
    s_mov_b32 s47, 2097152
L_s1:
    ds_read_b32 v28, v30 offset:256
    s_sub_u32 s47, s47, 1
    s_cbranch_scc1 L_s1x
    s_waitcnt lgkmcnt(0)
    v_cmp_gt_i32 vcc, 10, v28
    s_cbranch_vccnz L_s1
L_s1x:
    global_load_dwordx4 v[24:27], v14, s[26:27] offset:0 sc1
    v_lshlrev_b32 v16, 16, v16
    s_mov_b32 s47, 65536
    s_branch L_gfw
L_gf:
    s_sub_u32 s47, s47, 1
    s_cbranch_scc1 L_gfx
    s_mov_b64 exec, vcc
    global_load_dwordx4 v[24:27], v14, s[26:27] offset:0 sc1
L_gfw:
    s_waitcnt vmcnt(0)
L_gfc:
    v_perm_b32 v3, v25, v24, s44
    v_perm_b32 v4, v27, v26, s45
    v_bitop3_b32 v17, v3, v4, v12 bitop3:0x56
    v_cmp_lt_u32 vcc, 0, v17
    s_cbranch_vccnz L_gf
L_gfx:
    s_mov_b64 exec, -1
    v_and_b32 v20, s46, v24
    v_and_b32 v21, s46, v25
    v_and_b32 v22, s46, v26
    v_and_b32 v23, s46, v27
    s_nop 0
    v_permlane32_swap_b32 v20, v22
    v_permlane32_swap_b32 v21, v23
    v_add_f32 v20, v20, v22
    v_add_f32 v21, v21, v23
    s_nop 1
    v_permlane16_swap_b32 v20, v21
    v_add_f32 v20, v20, v21
    s_nop 1
    v_add_f32_dpp v20, v20, v20 row_ror:8 row_mask:0xf bank_mask:0xf
    s_nop 1
    v_add_f32_dpp v20, v20, v20 row_ror:4 row_mask:0xf bank_mask:0xf
    s_nop 1
    v_add_f32_dpp v20, v20, v20 row_ror:2 row_mask:0xf bank_mask:0xf
    s_nop 1
    v_add_f32_dpp v20, v20, v20 row_ror:1 row_mask:0xf bank_mask:0xf
    v_add_f32 v20, v20, v16
    v_cvt_pk_bf16_f32 v20, v20, v20
    s_mov_b64 exec, s[52:53]
    global_store_short v15, v20, s[22:23]
    s_cmp_eq_u32 s2, 0
    s_cbranch_scc0 L_lfin
    s_mov_b64 exec, 1
    global_store_dword v7, v12, s[26:27]
L_lfin:
    s_endpgm
L_comp:
    s_load_dwordx2 s[26:27], s[0:1], 88
    s_and_b32 s28, s2, 7
    s_lshr_b32 s29, s2, 3
    s_lshr_b32 s48, s29, 2
    s_and_b32 s49, s29, 3
    s_mov_b64 exec, -1
    v_and_b32 v1, 63, v0
    v_lshlrev_b32 v1, 4, v1
    v_mov_b32 v32, 0
    s_sub_u32 s30, s30, 1
    v_bfe_u32 v2, v0, 4, 2
    v_and_b32 v3, 15, v0
    s_mul_i32 s56, s28, 94208
    s_add_u32 s56, s56, 0x10000
    s_mul_i32 s3, s29, 2944
    s_add_u32 s3, s3, s56
    s_waitcnt lgkmcnt(0)
    s_load_dword s31, s[26:27], 0
    s_mov_b32 s40, 0x07060500
    s_mov_b32 s41, 0x07060501
    s_mov_b32 s42, 0x07060502
    s_mov_b32 s43, 0x07060503
    s_mov_b32 s39, 0xffff0000
    s_lshl_b32 s36, s30, 2
    v_mov_b32 v34, s36
    v_bfe_u32 v9, v0, 2, 4
    v_and_b32 v17, 6, v9
    v_bfe_u32 v18, v0, 1, 1
    s_lshl_b32 s37, s30, 1
    v_or_b32 v18, s37, v18
    v_xor_b32 v17, v17, v18
    v_lshlrev_b32 v17, 4, v17
    v_lshl_add_u32 v16, v9, 7, v17
    v_and_b32 v17, 1, v0
    v_lshl_add_u32 v16, v17, 3, v16
    s_lshl_b32 s36, s49, 8
    v_lshl_add_u32 v18, v2, 3, s36
    s_and_b32 s33, s29, 7
    s_lshl_b32 s36, s33, 7
    v_lshl_add_u32 v19, v2, 3, s36
    s_getreg_b32 s57, hwreg(20, 0, 4)
    v_add_u32 v21, v34, v2
    v_lshl_add_u32 v20, v21, 4, s3
    v_mov_b32 v25, 0x3b000000
    s_mov_b32 s52, 0x00010001
    s_mov_b32 s53, 0x00010001
    s_mov_b32 s47, 2097152
L_s2:
    ds_read_b32 v14, v32 offset:276
    ds_read_b128 v[152:155], v1 offset:4352
    s_sub_u32 s47, s47, 1
    s_cbranch_scc1 L_s2x
    s_waitcnt lgkmcnt(1)
    v_cmp_gt_i32 vcc, 1, v14
    s_cbranch_vccnz L_s2
L_s2x:
    s_waitcnt lgkmcnt(0)
    v_lshlrev_b32 v124, 16, v152
    v_and_b32 v125, s39, v152
    v_lshlrev_b32 v126, 16, v153
    v_and_b32 v127, s39, v153
    v_lshlrev_b32 v128, 16, v154
    v_and_b32 v129, s39, v154
    v_lshlrev_b32 v130, 16, v155
    v_and_b32 v131, s39, v155
    v_add_f32 v24, v124, v125
    v_add_f32 v24, v24, v126
    v_add_f32 v24, v24, v127
    v_add_f32 v24, v24, v128
    v_add_f32 v24, v24, v129
    v_add_f32 v24, v24, v130
    v_add_f32 v24, v24, v131
    s_add_u32 s31, s31, 0x3b5d7f29
    s_xor_b32 s36, s31, s57
    v_add_f32_dpp v24, v24, v24 row_ror:1 row_mask:0xf bank_mask:0xf
    v_mov_b32 v5, s36
    v_mov_b32 v4, s31
    v_add_f32_dpp v24, v24, v24 row_ror:2 row_mask:0xf bank_mask:0xf
    v_cmp_eq_u32 s[32:33], 1, v17
    v_and_b32 v11, 7, v0
    v_add_f32_dpp v24, v24, v24 row_ror:4 row_mask:0xf bank_mask:0xf
    v_lshl_add_u32 v21, v21, 1, v17
    v_lshl_add_u32 v35, v21, 4, s3
    v_add_f32_dpp v24, v24, v24 row_ror:8 row_mask:0xf bank_mask:0xf
    s_mov_b32 s54, 0x00030003
    s_mov_b32 s55, 0x00030003
    v_add_f32_dpp v24, v24, v24 row_bcast:15 row_mask:0xa bank_mask:0xf
    s_mov_b32 s44, 0x0c0c0400
    s_mov_b32 s45, 0x04000c0c
    v_add_f32_dpp v24, v24, v24 row_bcast:31 row_mask:0xc bank_mask:0xf
    s_mov_b32 s46, 0xffffff00
    v_readlane_b32 s50, v24, 63
    s_nop 1
    v_mul_f32 v26, s50, v25
    v_sub_f32 v132, v124, v26
    v_sub_f32 v133, v125, v26
    v_sub_f32 v134, v126, v26
    v_sub_f32 v135, v127, v26
    v_sub_f32 v136, v128, v26
    v_sub_f32 v137, v129, v26
    v_sub_f32 v138, v130, v26
    v_sub_f32 v139, v131, v26
    v_mul_f32 v24, v132, v132
    v_fmac_f32 v24, v133, v133
    v_fmac_f32 v24, v134, v134
    v_fmac_f32 v24, v135, v135
    v_fmac_f32 v24, v136, v136
    v_fmac_f32 v24, v137, v137
    v_fmac_f32 v24, v138, v138
    v_fmac_f32 v24, v139, v139
    v_cvt_pk_bf16_f32 v26, v26, v26
    v_and_b32 v26, s39, v26
    v_add_f32_dpp v24, v24, v24 row_ror:1 row_mask:0xf bank_mask:0xf
    v_sub_f32 v124, v124, v26
    v_sub_f32 v125, v125, v26
    v_add_f32_dpp v24, v24, v24 row_ror:2 row_mask:0xf bank_mask:0xf
    v_sub_f32 v126, v126, v26
    v_sub_f32 v127, v127, v26
    v_add_f32_dpp v24, v24, v24 row_ror:4 row_mask:0xf bank_mask:0xf
    v_sub_f32 v128, v128, v26
    v_sub_f32 v129, v129, v26
    v_add_f32_dpp v24, v24, v24 row_ror:8 row_mask:0xf bank_mask:0xf
    v_sub_f32 v130, v130, v26
    v_sub_f32 v131, v131, v26
    v_add_f32_dpp v24, v24, v24 row_bcast:15 row_mask:0xa bank_mask:0xf
    v_cvt_pk_bf16_f32 v132, v124, v125
    v_cvt_pk_bf16_f32 v133, v126, v127
    v_add_f32_dpp v24, v24, v24 row_bcast:31 row_mask:0xc bank_mask:0xf
    v_cvt_pk_bf16_f32 v134, v128, v129
    v_cvt_pk_bf16_f32 v135, v130, v131
    v_readlane_b32 s51, v24, 63
    v_lshlrev_b32 v124, 16, v132
    v_and_b32 v125, s39, v132
    v_lshlrev_b32 v126, 16, v133
    v_and_b32 v127, s39, v133
    v_lshlrev_b32 v128, 16, v134
    v_and_b32 v129, s39, v134
    v_lshlrev_b32 v130, 16, v135
    v_and_b32 v131, s39, v135
    v_mul_f32 v27, s51, v25
    v_cvt_pk_bf16_f32 v27, v27, v27
    v_and_b32 v27, s39, v27
    v_add_f32 v27, 0x3727c5ac, v27
    v_cvt_pk_bf16_f32 v27, v27, v27
    v_and_b32 v27, s39, v27
    v_sqrt_f32 v27, v27
    s_nop 0
    v_cvt_pk_bf16_f32 v27, v27, v27
    v_and_b32 v27, s39, v27
    v_rcp_f32 v27, v27
    s_nop 0
    v_mul_f32 v124, v124, v27
    v_mul_f32 v125, v125, v27
    v_mul_f32 v126, v126, v27
    v_mul_f32 v127, v127, v27
    v_mul_f32 v128, v128, v27
    v_mul_f32 v129, v129, v27
    v_mul_f32 v130, v130, v27
    v_mul_f32 v131, v131, v27
    v_cvt_pk_bf16_f32 v152, v124, v125
    v_cvt_pk_bf16_f32 v153, v126, v127
    v_cvt_pk_bf16_f32 v154, v128, v129
    v_cvt_pk_bf16_f32 v155, v130, v131
    ds_write_b128 v1, v[152:155] offset:1280
    ds_read2_b64 v[44:47], v18 offset0:160 offset1:164
    ds_read2_b64 v[48:51], v18 offset0:168 offset1:172
    ds_read2_b64 v[52:55], v18 offset0:176 offset1:180
    ds_read2_b64 v[56:59], v18 offset0:184 offset1:188
    ds_read2_b64 v[60:63], v19 offset0:160 offset1:164
    ds_read2_b64 v[64:67], v19 offset0:168 offset1:172
L_padC:
    s_cbranch_execz L_comp
    s_mov_b32 s47, 2097152
L_s3:
    ds_read_b32 v14, v32 offset:276
    s_sub_u32 s47, s47, 1
    s_cbranch_scc1 L_s3x
    s_waitcnt lgkmcnt(0)
    v_cmp_gt_i32 vcc, 17, v14
    s_cbranch_vccnz L_s3
L_s3x:
    ds_read_b64_tr_b16 v[68:69], v16 offset:5376
    ds_read_b64_tr_b16 v[70:71], v16 offset:7424
    ds_read_b64_tr_b16 v[72:73], v16 offset:9472
    ds_read_b64_tr_b16 v[74:75], v16 offset:11520
    ds_read_b64_tr_b16 v[76:77], v16 offset:13568
    ds_read_b64_tr_b16 v[78:79], v16 offset:15616
    ds_read_b64_tr_b16 v[80:81], v16 offset:17664
    ds_read_b64_tr_b16 v[82:83], v16 offset:19712
    s_waitcnt lgkmcnt(6)
    v_mfma_f32_16x16x32_bf16 v[168:171], v[68:71], v[44:47], 0
    s_waitcnt lgkmcnt(4)
    v_mfma_f32_16x16x32_bf16 v[168:171], v[72:75], v[48:51], v[168:171]
    s_waitcnt lgkmcnt(2)
    v_mfma_f32_16x16x32_bf16 v[168:171], v[76:79], v[52:55], v[168:171]
    s_waitcnt lgkmcnt(0)
    v_mfma_f32_16x16x32_bf16 v[168:171], v[80:83], v[56:59], v[168:171]
    v_bfe_u32 v23, v0, 5, 1
    v_bfe_u32 v24, v0, 4, 1
    v_lshl_add_u32 v22, v24, 1, v23
    v_add_u32 v22, v22, v34
    v_mul_u32_u24 v29, 5888, v22
    v_lshlrev_b32 v22, 4, v3
    v_add3_u32 v29, v29, v22, s56
    s_mov_b64 exec, s[52:53]
    v_perm_b32 v168, v168, v5, s40
    v_perm_b32 v169, v169, v5, s41
    v_perm_b32 v170, v170, v5, s42
    v_perm_b32 v171, v171, v5, s43
    global_store_dwordx4 v20, v[168:171], s[26:27]
    s_mov_b64 exec, -1
    v_add_u32 v21, 0xc0000, v20
    v_and_b32 v22, 31, v0
    v_lshl_add_u32 v22, v22, 1, v23
    v_lshlrev_b32 v22, 2, v22
    v_lshl_add_u32 v22, v34, 6, v22
    v_lshlrev_b32 v23, 4, v2
    s_cmp_eq_u32 s28, 0
    s_cselect_b32 s59, 24, 0
    s_sub_u32 s59, 121, s59
    s_cmp_eq_u32 s28, 0
    s_cselect_b32 s58, 24, 0
    s_sub_u32 s58, 113, s58
    s_min_u32 s37, s28, 1
    v_cmp_lt_u32 vcc, 4, v11
    v_mov_b32 v12, s59
    v_mov_b32 v13, s58
    v_mov_b32 v10, s37
    v_cndmask_b32 v12, 0, v12, vcc
    v_cndmask_b32 v13, v10, v13, vcc
    v_cmp_gt_u32 vcc, 4, v11
    v_lshlrev_b32 v11, 2, v11
    v_and_b32 v10, 12, v11
    v_cndmask_b32 v12, v12, 10, vcc
    s_lshl2_add_u32 s36, s48, s30
    s_lshl_b32 s36, s36, 6
    s_add_u32 s36, s36, s56
    v_mul_u32_u24 v31, 5888, v3
    v_add3_u32 v31, v31, v23, s36
    s_lshl3_add_u32 s36, s49, s28
    s_lshl3_add_u32 s36, s36, s48
    s_lshl2_add_u32 s36, s36, s30
    s_lshl_b32 s36, s36, 7
    s_add_u32 s36, s36, 0x190000
    v_lshl_add_u32 v8, v17, 6, v23
    v_add_u32 v36, s36, v8
    v_bfe_u32 v24, v0, 2, 2
    v_bfe_u32 v37, v0, 1, 3
    v_xor_b32 v37, v37, v34
    v_lshl_add_u32 v37, v37, 1, v17
    v_lshlrev_b32 v37, 3, v37
    v_lshl_add_u32 v37, v24, 8, v37
    v_lshl_add_u32 v37, v2, 11, v37
    v_xor_b32 v38, 32, v37
    v_bfe_u32 v6, v0, 1, 4
    v_xor_b32 v6, v6, v34
    v_lshl_add_u32 v6, v6, 1, v17
    v_lshlrev_b32 v9, 4, v9
    v_lshl_add_u32 v6, v9, 1, v6
    s_mov_b32 s36, 95488
    v_lshl_add_u32 v6, v6, 3, s36
    v_xor_b32 v7, 32, v6
    s_lshl_b32 s36, s30, 7
    s_add_u32 s36, s36, s3
    v_lshlrev_b32 v18, 9, v24
    v_add3_u32 v8, v8, v18, s36
    v_bfrev_b32 v40, v24
    v_lshrrev_b32 v40, 30, v40
    v_add_u32 v40, v40, v34
    v_lshl_add_u32 v40, v40, 2, v2
    v_lshlrev_b32 v40, 1, v40
L_padD:
    s_cbranch_execz L_comp
    v_xor_b32 v172, v2, v3
    v_lshlrev_b32 v172, 4, v172
    v_lshl_add_u32 v172, v3, 8, v172
    s_lshl_b32 s36, s30, 13
    s_add_u32 s36, s36, 62720
    v_add_u32 v172, s36, v172
    v_xor_b32 v173, 64, v172
    v_xor_b32 v174, 128, v172
    v_xor_b32 v175, 192, v172
    s_cmp_eq_u32 s28, 0
    s_cselect_b32 s35, 25, 41
    s_lshl3_add_u32 s35, s30, s35
    v_lshl_add_u32 v25, v24, 8, v23
    v_lshlrev_b32 v24, 4, v24
    v_add_u32 v19, v24, v34
    v_lshl_add_u32 v18, v34, 6, v9
    v_and_b32 v20, 0x400, v16
    v_add_u32 v16, v16, v20
    s_cmp_eq_u32 s28, 0
    s_cbranch_scc1 L_ngu
    s_mov_b32 s47, 2097152
L_s4:
    ds_read_b32 v14, v32 offset:276
    s_sub_u32 s47, s47, 1
    s_cbranch_scc1 L_s4x
    s_waitcnt lgkmcnt(0)
    v_cmp_gt_i32 vcc, 33, v14
    s_cbranch_vccnz L_s4
L_s4x:
    ds_read_b64_tr_b16 v[100:101], v16 offset:21760
    ds_read_b64_tr_b16 v[102:103], v16 offset:25856
    ds_read_b64_tr_b16 v[104:105], v16 offset:29952
    ds_read_b64_tr_b16 v[106:107], v16 offset:34048
    ds_read_b64_tr_b16 v[108:109], v16 offset:22784
    ds_read_b64_tr_b16 v[110:111], v16 offset:26880
    ds_read_b64_tr_b16 v[112:113], v16 offset:30976
    ds_read_b64_tr_b16 v[114:115], v16 offset:35072
    s_waitcnt lgkmcnt(6)
    v_mfma_f32_16x16x32_bf16 v[140:143], v[100:103], v[60:63], 0
    s_waitcnt lgkmcnt(4)
    v_mfma_f32_16x16x32_bf16 v[140:143], v[104:107], v[64:67], v[140:143]
    s_waitcnt lgkmcnt(2)
    v_mfma_f32_16x16x32_bf16 v[144:147], v[108:111], v[60:63], 0
    s_waitcnt lgkmcnt(0)
    v_mfma_f32_16x16x32_bf16 v[144:147], v[112:115], v[64:67], v[144:147]
    s_mov_b64 exec, s[54:55]
    s_nop 2
    v_cndmask_b32 v180, v140, v142, s[32:33]
    v_cndmask_b32 v181, v141, v143, s[32:33]
    s_nop 1
    v_cndmask_b32 v182, v144, v146, s[32:33]
    v_cndmask_b32 v183, v145, v147, s[32:33]
    v_perm_b32 v180, v180, v4, s40
    v_perm_b32 v181, v181, v4, s41
    v_perm_b32 v182, v182, v4, s42
    v_perm_b32 v183, v183, v4, s43
    global_store_dwordx4 v35, v[180:183], s[26:27] offset:256
    s_mov_b64 exec, -1
L_ngu:
    v_mov_b32 v192, 0x3f803f80
    v_mov_b32 v193, 0x3f803f80
    v_mov_b32 v194, 0x3f803f80
    v_mov_b32 v195, 0x3f803f80
    v_mov_b32 v184, 0
    v_mov_b32 v185, 0
    v_mov_b32 v186, 0
    v_mov_b32 v187, 0
    v_mov_b32 v188, 0
    v_mov_b32 v189, 0
    v_mov_b32 v190, 0
    v_mov_b32 v191, 0
    s_mov_b32 s50, 0x33333333
    s_mov_b32 s51, 0x33333333
    s_mov_b32 s34, 0x3e0293ee
    s_cmp_eq_u32 s28, 0
    s_cselect_b32 s58, 16, 0
    s_sub_u32 s58, 97, s58
    s_mov_b32 s47, 2097152
L_s5:
    ds_read_b32 v14, v32 offset:276
    s_sub_u32 s47, s47, 1
    s_cbranch_scc1 L_s5x
    s_waitcnt lgkmcnt(0)
    v_cmp_gt_i32 vcc, 49, v14
    s_cbranch_vccnz L_s5
L_s5x:
    global_load_dwordx4 v[160:163], v29, s[26:27] offset:0 sc1
    global_load_dwordx4 v[164:167], v29, s[26:27] offset:2944 sc1
    s_mov_b64 exec, s[52:53]
    global_store_dwordx4 v21, v[168:171], s[26:27] sc1
    s_mov_b64 exec, -1
    s_mov_b32 s47, 2097152
L_s6:
    ds_read_b32 v14, v32 offset:276
    s_sub_u32 s47, s47, 1
    s_cbranch_scc1 L_s6x
    s_waitcnt lgkmcnt(0)
    v_cmp_gt_i32 vcc, s35, v14
    s_cbranch_vccnz L_s6
L_s6x:
    ds_read_b128 v[68:71], v172 offset:0
    ds_read_b128 v[72:75], v173 offset:0
    ds_read_b128 v[76:79], v174 offset:0
    ds_read_b128 v[80:83], v175 offset:0
    ds_read_b128 v[84:87], v172 offset:4096
    ds_read_b128 v[88:91], v173 offset:4096
    ds_read_b128 v[92:95], v174 offset:4096
    ds_read_b128 v[96:99], v175 offset:4096
    s_mov_b32 s47, 65536
    s_waitcnt vmcnt(1)
    s_branch L_gqc
L_gq:
    s_sub_u32 s47, s47, 1
    s_cbranch_scc1 L_gqx
    s_mov_b64 exec, vcc
    s_cmp_eq_u32 s47, 65512
    s_cselect_b32 s36, 0xc0000, 0
    v_add_u32 v29, s36, v29
    global_load_dwordx4 v[160:163], v29, s[26:27] offset:0 sc1
    global_load_dwordx4 v[164:167], v29, s[26:27] offset:2944 sc1
L_gqw:
    s_waitcnt vmcnt(0)
L_gqc:
    v_perm_b32 v26, v161, v160, s44
    v_perm_b32 v27, v163, v162, s45
    v_bitop3_b32 v28, v26, v27, v5 bitop3:0x56
    v_perm_b32 v26, v165, v164, s44
    v_perm_b32 v27, v167, v166, s45
    v_bitop3_b32 v26, v26, v27, v5 bitop3:0x56
    v_or_b32 v28, v28, v26
    v_cmp_lt_u32 vcc, 15, v28
    s_cbranch_vccnz L_gq
L_gqx:
    s_mov_b64 exec, -1
    v_cmp_ne_u32 vcc, 0, v28
    v_and_b32 v152, s46, v160
    v_and_b32 v153, s46, v161
    v_and_b32 v154, s46, v162
    v_and_b32 v155, s46, v163
    v_and_b32 v156, s46, v164
    v_and_b32 v157, s46, v165
    v_and_b32 v158, s46, v166
    v_and_b32 v159, s46, v167
    s_cmp_lg_u64 vcc, 0
    s_cselect_b32 s36, 3, 2
    v_mov_b32 v33, s36
    v_add_f32 v152, v152, v156
    v_add_f32 v153, v153, v157
    v_add_f32 v154, v154, v158
    v_add_f32 v155, v155, v159
    s_nop 0
    v_permlane32_swap_b32 v152, v154
    v_permlane32_swap_b32 v153, v155
    v_add_f32 v152, v152, v154
    v_add_f32 v153, v153, v155
    v_cvt_pk_bf16_f32 v152, v152, v153
    ds_write_b32 v22, v152 offset:2304
    ds_write_b32 v34, v33 offset:256
    v_add_u32 v33, 2, v33
    s_mov_b32 s47, 2097152
L_s7:
    ds_read_b32 v14, v10 offset:256
    ds_read_b128 v[44:47], v25 offset:2304
    ds_read_b128 v[48:51], v25 offset:2368
    ds_read_b128 v[52:55], v25 offset:2432
    ds_read_b128 v[56:59], v25 offset:2496
    s_sub_u32 s47, s47, 1
    s_cbranch_scc1 L_s7x
    s_waitcnt lgkmcnt(4)
    v_cmp_gt_i32 vcc, 2, v14
    s_cbranch_vccnz L_s7
L_s7x:
    v_and_b32 v14, 1, v14
    s_waitcnt lgkmcnt(3)
    v_mfma_f32_16x16x32_bf16 v[172:175], v[68:71], v[44:47], 0
    v_mfma_f32_16x16x32_bf16 v[176:179], v[84:87], v[44:47], 0
    s_waitcnt lgkmcnt(2)
    v_mfma_f32_16x16x32_bf16 v[172:175], v[72:75], v[48:51], v[172:175]
    v_mfma_f32_16x16x32_bf16 v[176:179], v[88:91], v[48:51], v[176:179]
    s_waitcnt lgkmcnt(1)
    v_mfma_f32_16x16x32_bf16 v[172:175], v[76:79], v[52:55], v[172:175]
    v_mfma_f32_16x16x32_bf16 v[176:179], v[92:95], v[52:55], v[176:179]
    s_waitcnt lgkmcnt(0)
    v_mfma_f32_16x16x32_bf16 v[172:175], v[80:83], v[56:59], v[172:175]
    v_mfma_f32_16x16x32_bf16 v[176:179], v[96:99], v[56:59], v[176:179]
    v_cmp_ne_u32 vcc, 0, v14
L_padE:
    s_cbranch_execz L_padF
    s_mov_b32 s57, vcc_lo
    s_nop 3
    v_max3_f32 v16, v172, v173, v174
    v_max3_f32 v17, v175, v176, v177
    v_max3_f32 v16, v16, v178, v179
    v_max_f32 v20, v16, v17
    v_max_f32 v16, v16, v17
    s_nop 1
    v_permlane32_swap_b32 v16, v20
    v_max_f32 v17, v16, v20
    v_max_f32 v16, v16, v20
    s_nop 1
    v_permlane16_swap_b32 v16, v17
    v_max_f32 v16, v16, v17
    ds_write_b32 v19, v16 offset:0
    ds_write_b32 v34, v33 offset:256
    v_add_u32 v33, 2, v33
    s_cmp_eq_u32 s57, 0
    s_cbranch_scc0 L_rs_1
L_rs_1b:
    s_mov_b32 s47, 2097152
L_s8:
    ds_read_b32 v14, v10 offset:256
    ds_read_b128 v[152:155], v24 offset:0
    ds_read_b32 v15, v32 offset:276
    s_sub_u32 s47, s47, 1
    s_cbranch_scc1 L_s8x
    s_waitcnt lgkmcnt(2)
    v_cmp_gt_i32 vcc, 4, v14
    s_cbranch_vccnz L_s8
L_s8x:
    s_waitcnt lgkmcnt(0)
    v_max3_f32 v16, v152, v153, v154
    v_max_f32 v16, v16, v155
    v_mul_f32 v16, s34, v16
    v_cmp_gt_i32 s[4:5], s58, v15
    v_fma_f32 v172, v172, s34, -v16
    v_fma_f32 v173, v173, s34, -v16
    v_fma_f32 v174, v174, s34, -v16
    v_fma_f32 v175, v175, s34, -v16
    v_fma_f32 v176, v176, s34, -v16
    v_fma_f32 v177, v177, s34, -v16
    v_fma_f32 v178, v178, s34, -v16
    v_fma_f32 v179, v179, s34, -v16
    v_exp_f32 v172, v172
    v_exp_f32 v173, v173
    v_exp_f32 v174, v174
    v_exp_f32 v175, v175
    v_exp_f32 v176, v176
    v_exp_f32 v177, v177
    v_exp_f32 v178, v178
    v_exp_f32 v179, v179
    v_cvt_pk_bf16_f32 v152, v172, v173
    v_cvt_pk_bf16_f32 v153, v174, v175
    v_cvt_pk_bf16_f32 v154, v176, v177
    v_cvt_pk_bf16_f32 v155, v178, v179
    ds_write_b128 v18, v[152:155] offset:3328
    ds_write_b32 v34, v33 offset:256
    v_add_u32 v33, 2, v33
    s_cmp_lg_u32 s4, 0
    s_cbranch_scc0 L_vhere
    s_mov_b32 s47, 2097152
L_s10:
    ds_read_b32 v14, v10 offset:256
    ds_read_b128 v[44:47], v9 offset:3328
    ds_read_b128 v[48:51], v9 offset:3584
    ds_read_b128 v[52:55], v9 offset:3840
    ds_read_b128 v[56:59], v9 offset:4096
    s_sub_u32 s47, s47, 1
    s_cbranch_scc1 L_s10x
    s_waitcnt lgkmcnt(4)
    v_cmp_gt_i32 vcc, 6, v14
    s_cbranch_vccnz L_s10
L_s10x:
    s_sub_u32 s38, s58, 8
    s_waitcnt lgkmcnt(3)
    v_mfma_f32_16x16x32_bf16 v[148:151], v[192:195], v[44:47], 0
    s_waitcnt lgkmcnt(2)
    v_mfma_f32_16x16x32_bf16 v[148:151], v[192:195], v[48:51], v[148:151]
    s_waitcnt lgkmcnt(1)
    v_mfma_f32_16x16x32_bf16 v[148:151], v[192:195], v[52:55], v[148:151]
    s_waitcnt lgkmcnt(0)
    v_mfma_f32_16x16x32_bf16 v[148:151], v[192:195], v[56:59], v[148:151]
L_padF:
    s_cbranch_execz L_aux2
    s_mov_b32 s47, 2097152
L_s11:
    ds_read_b32 v14, v32 offset:276
    s_sub_u32 s47, s47, 1
    s_cbranch_scc1 L_s11x
    s_waitcnt lgkmcnt(0)
    v_cmp_gt_i32 vcc, s38, v14
    s_cbranch_vccnz L_s11
L_s11x:
    ds_read_b64_tr_b16 v[68:69], v6 offset:0
    ds_read_b64_tr_b16 v[70:71], v6 offset:4096
    ds_read_b64_tr_b16 v[72:73], v7 offset:0
    ds_read_b64_tr_b16 v[74:75], v7 offset:4096
    ds_read_b64_tr_b16 v[76:77], v6 offset:8192
    ds_read_b64_tr_b16 v[78:79], v6 offset:12288
    ds_read_b64_tr_b16 v[80:81], v7 offset:8192
    ds_read_b64_tr_b16 v[82:83], v7 offset:12288
    ds_read_b64_tr_b16 v[84:85], v6 offset:16384
    ds_read_b64_tr_b16 v[86:87], v6 offset:20480
    ds_read_b64_tr_b16 v[88:89], v7 offset:16384
    ds_read_b64_tr_b16 v[90:91], v7 offset:20480
    v_log_f32 v126, v148
    v_rcp_f32 v17, v148
    v_mov_b32 v127, v4
    v_add_f32 v126, v126, v16
    s_waitcnt lgkmcnt(8)
    v_mfma_f32_16x16x32_bf16 v[140:143], v[68:71], v[44:47], 0
    v_mfma_f32_16x16x32_bf16 v[144:147], v[72:75], v[44:47], 0
    s_waitcnt lgkmcnt(4)
    v_mfma_f32_16x16x32_bf16 v[140:143], v[76:79], v[48:51], v[140:143]
    v_mfma_f32_16x16x32_bf16 v[144:147], v[80:83], v[48:51], v[144:147]
    s_waitcnt lgkmcnt(0)
    v_mfma_f32_16x16x32_bf16 v[140:143], v[84:87], v[52:55], v[140:143]
    v_mfma_f32_16x16x32_bf16 v[144:147], v[88:91], v[52:55], v[144:147]
    s_mov_b32 s47, 2097152
L_s12:
    ds_read_b32 v14, v32 offset:276
    ds_read_b64_tr_b16 v[92:93], v6 offset:24576
    ds_read_b64_tr_b16 v[94:95], v6 offset:28672
    ds_read_b64_tr_b16 v[96:97], v7 offset:24576
    ds_read_b64_tr_b16 v[98:99], v7 offset:28672
    s_sub_u32 s47, s47, 1
    s_cbranch_scc1 L_s12x
    s_waitcnt lgkmcnt(4)
    v_cmp_gt_i32 vcc, s58, v14
    s_cbranch_vccnz L_s12
L_s12x:
L_vlast:
    s_waitcnt lgkmcnt(2)
    v_mfma_f32_16x16x32_bf16 v[140:143], v[92:95], v[56:59], v[140:143]
    s_waitcnt lgkmcnt(0)
    v_mfma_f32_16x16x32_bf16 v[144:147], v[96:99], v[56:59], v[144:147]
    s_mov_b64 exec, s[50:51]
    s_nop 6
    v_cndmask_b32 v128, v140, v144, s[32:33]
    v_cndmask_b32 v129, v141, v145, s[32:33]
    v_cndmask_b32 v130, v142, v146, s[32:33]
    v_cndmask_b32 v131, v143, v147, s[32:33]
    v_mul_f32 v128, v128, v17
    v_mul_f32 v129, v129, v17
    v_mul_f32 v130, v130, v17
    v_mul_f32 v131, v131, v17
    v_cvt_pk_bf16_f32 v124, v128, v129
    v_cvt_pk_bf16_f32 v125, v130, v131
    global_store_dwordx4 v8, v[124:127], s[26:27] offset:768
    s_cmp_eq_u32 s57, 0
    s_cbranch_scc0 L_rs_2
L_rs_2b:
    s_mov_b64 exec, -1
    ds_write_b32 v34, v33 offset:256
    v_add_u32 v33, 2, v33
    s_mov_b32 s47, 2097152
L_s13:
    ds_read_b32 v14, v10 offset:256
    s_sub_u32 s47, s47, 1
    s_cbranch_scc1 L_s13x
    s_waitcnt lgkmcnt(0)
    v_cmp_gt_i32 vcc, 8, v14
    s_cbranch_vccnz L_s13
L_s13x:
    global_load_dwordx4 v[152:155], v31, s[26:27] offset:768 sc1
    global_load_dwordx4 v[156:159], v31, s[26:27] offset:3712 sc1
    s_mov_b32 s47, 2097152
L_s14:
    ds_read_b32 v14, v11 offset:256
    s_sub_u32 s47, s47, 1
    s_cbranch_scc1 L_s14x
    s_waitcnt lgkmcnt(0)
    v_cmp_gt_i32 vcc, v13, v14
    s_cbranch_vccnz L_s14
L_s14x:
    ds_read_b128 v[132:135], v23 offset:64
    ds_read_b64_tr_b16 v[116:117], v37 offset:38144
    ds_read_b64_tr_b16 v[118:119], v37 offset:39168
    ds_read_b64_tr_b16 v[120:121], v38 offset:38144
    ds_read_b64_tr_b16 v[122:123], v38 offset:39168
    ds_read_b64_tr_b16 v[100:101], v37 offset:46336
    ds_read_b64_tr_b16 v[102:103], v37 offset:47360
    ds_read_b64_tr_b16 v[108:109], v38 offset:46336
    ds_read_b64_tr_b16 v[110:111], v38 offset:47360
    s_cmp_eq_u32 s28, 0
    s_cbranch_scc1 L_ndn
    s_waitcnt lgkmcnt(4)
    v_mfma_f32_16x16x32_bf16 v[184:187], v[116:119], v[132:135], v[184:187]
    v_mfma_f32_16x16x32_bf16 v[188:191], v[120:123], v[132:135], v[188:191]
L_ndn:
    s_mov_b32 s47, 65536
    s_branch L_gow
L_go:
    s_sub_u32 s47, s47, 1
    s_cbranch_scc1 L_gox
    s_mov_b64 exec, vcc
    global_load_dwordx4 v[152:155], v31, s[26:27] offset:768 sc1
    global_load_dwordx4 v[156:159], v31, s[26:27] offset:3712 sc1
L_gow:
    s_waitcnt vmcnt(0)
L_goc:
    v_cmp_ne_u32 vcc, v155, v4
    v_cmp_ne_u32 s[36:37], v159, v4
    s_or_b64 vcc, vcc, s[36:37]
    s_cbranch_vccnz L_go
L_gox:
    s_mov_b64 exec, -1
    v_max_f32 v16, v154, v158
    v_lshlrev_b32 v172, 16, v152
    v_and_b32 v173, s39, v152
    v_max_f32_dpp v16, v16, v16 row_ror:8 row_mask:0xf bank_mask:0xf
    v_lshlrev_b32 v174, 16, v153
    v_and_b32 v175, s39, v153
    v_max_f32_dpp v16, v16, v16 row_ror:4 row_mask:0xf bank_mask:0xf
    v_lshlrev_b32 v176, 16, v156
    v_and_b32 v177, s39, v156
    v_max_f32_dpp v16, v16, v16 row_ror:2 row_mask:0xf bank_mask:0xf
    v_lshlrev_b32 v178, 16, v157
    v_and_b32 v179, s39, v157
    v_max_f32_dpp v16, v16, v16 row_ror:1 row_mask:0xf bank_mask:0xf
    v_sub_f32 v20, v154, v16
    v_sub_f32 v21, v158, v16
    v_exp_f32 v20, v20
    v_exp_f32 v21, v21
    v_mul_f32 v172, v172, v20
    v_mul_f32 v173, v173, v20
    v_mul_f32 v174, v174, v20
    v_mul_f32 v175, v175, v20
    v_add_f32 v17, v20, v21
    v_fmac_f32 v172, v176, v21
    v_fmac_f32 v173, v177, v21
    v_fmac_f32 v174, v178, v21
    v_fmac_f32 v175, v179, v21
    v_add_f32_dpp v17, v17, v17 row_ror:8 row_mask:0xf bank_mask:0xf
    v_add_f32_dpp v172, v172, v172 row_ror:8 row_mask:0xf bank_mask:0xf
    v_add_f32_dpp v172, v173, v173 row_ror:8 row_mask:0xf bank_mask:0xc
    v_add_f32_dpp v17, v17, v17 row_ror:4 row_mask:0xf bank_mask:0xf
    v_add_f32_dpp v174, v174, v174 row_ror:8 row_mask:0xf bank_mask:0xf
    v_add_f32_dpp v174, v175, v175 row_ror:8 row_mask:0xf bank_mask:0xc
    v_add_f32_dpp v17, v17, v17 row_ror:2 row_mask:0xf bank_mask:0xf
    v_add_f32_dpp v172, v172, v172 row_shl:4 row_mask:0xf bank_mask:0x5
    v_add_f32_dpp v172, v174, v174 row_shr:4 row_mask:0xf bank_mask:0xa
    v_add_f32_dpp v17, v17, v17 row_ror:1 row_mask:0xf bank_mask:0xf
    v_rcp_f32 v17, v17
    v_add_f32_dpp v172, v172, v172 quad_perm:[1,0,3,2] row_mask:0xf bank_mask:0xf
    s_nop 1
    v_add_f32_dpp v172, v172, v172 quad_perm:[2,3,0,1] row_mask:0xf bank_mask:0xf
    v_mul_f32 v172, v172, v17
    v_cvt_pk_bf16_f32 v172, v172, v172
    ds_write_b16 v40, v172 offset:128
    ds_write_b32 v34, v33 offset:256
    s_mov_b32 s47, 2097152
L_s15:
    ds_read_b32 v14, v11 offset:256
    ds_read_b128 v[44:47], v23 offset:128
    ds_read_b128 v[48:51], v23 offset:192
    ds_read_b64_tr_b16 v[104:105], v37 offset:54528
    ds_read_b64_tr_b16 v[106:107], v37 offset:55552
    ds_read_b64_tr_b16 v[112:113], v38 offset:54528
    ds_read_b64_tr_b16 v[114:115], v38 offset:55552
    s_sub_u32 s47, s47, 1
    s_cbranch_scc1 L_s15x
    s_waitcnt lgkmcnt(6)
    v_cmp_gt_i32 vcc, v12, v14
    s_cbranch_vccnz L_s15
L_s15x:
    s_waitcnt lgkmcnt(5)
    v_mfma_f32_16x16x32_bf16 v[184:187], v[100:103], v[44:47], v[184:187]
    v_mfma_f32_16x16x32_bf16 v[188:191], v[108:111], v[44:47], v[188:191]
    s_waitcnt lgkmcnt(2)
    v_mfma_f32_16x16x32_bf16 v[184:187], v[104:107], v[48:51], v[184:187]
    s_waitcnt lgkmcnt(0)
    v_mfma_f32_16x16x32_bf16 v[188:191], v[112:115], v[48:51], v[188:191]
    s_mov_b64 exec, s[54:55]
    s_nop 6
    v_cndmask_b32 v124, v184, v188, s[32:33]
    v_cndmask_b32 v125, v185, v189, s[32:33]
    v_cndmask_b32 v126, v186, v190, s[32:33]
    v_cndmask_b32 v127, v187, v191, s[32:33]
    v_perm_b32 v124, v124, v4, s40
    v_perm_b32 v125, v125, v4, s41
    v_perm_b32 v126, v126, v4, s42
    v_perm_b32 v127, v127, v4, s43
    global_store_dwordx4 v36, v[124:127], s[26:27] sc1
L_end:
    s_endpgm
L_aux:
    s_load_dwordx2 s[26:27], s[0:1], 88
    s_and_b32 s28, s2, 7
    s_lshr_b32 s29, s2, 3
    s_lshr_b32 s48, s29, 2
    s_and_b32 s49, s29, 3
    v_and_b32 v0, 63, v0
    s_mul_i32 s56, s28, 94208
    s_add_u32 s56, s56, 0x10000
    s_mul_i32 s3, s29, 2944
    s_add_u32 s3, s3, s56
    v_lshl_add_u32 v12, v0, 7, s3
    s_lshr_b32 s37, s28, 1
    s_lshl_b32 s37, s37, 5
    s_add_u32 s37, s37, s29
    s_and_b32 s36, s28, 1
    s_lshl2_add_u32 s36, s37, s36
    s_lshl_b32 s36, s36, 8
    s_add_u32 s36, s36, 0x190000
    v_lshl_add_u32 v13, v0, 7, s36
    s_waitcnt lgkmcnt(0)
    s_load_dword s31, s[26:27], 0
    s_bfm_b64 exec, 22, 0
    global_load_dword v8, v12, s[26:27]
    s_mov_b64 exec, 0x33
    global_load_dword v8, v13, s[26:27]
    s_mov_b64 exec, 0
    s_branch L_padE
L_aux2:
    s_mov_b64 exec, -1
    s_cmp_eq_u32 s28, 0
    s_cbranch_scc1 L_end
    s_and_b32 s37, s48, 1
    s_lshr_b32 s36, s48, 1
    s_mulk_i32 s36, 23552
    s_lshl_b32 s37, s37, 8
    s_add_u32 s36, s36, s37
    s_add_u32 s36, s36, s56
    v_and_b32 v6, 7, v0
    v_mul_u32_u24 v6, 2944, v6
    v_and_b32 v12, 0x38, v0
    v_lshlrev_b32 v12, 1, v12
    v_add3_u32 v6, v6, v12, s36
    v_lshrrev_b32 v7, 4, v0
    v_and_b32 v12, 8, v0
    v_add_u32 v7, v7, v12
    v_and_b32 v12, 4, v0
    v_lshl_add_u32 v7, v12, 2, v7
    v_lshlrev_b32 v7, 1, v7
    v_mov_b32 v3, 0
    s_mov_b32 s44, 0x0c0c0400
    s_mov_b32 s45, 0x04000c0c
    s_mov_b32 s46, 0xffffff00
    s_mov_b32 s39, 0xffff0000
    s_mov_b32 s47, 2097152
L_s16:
    ds_read_b32 v5, v3 offset:276
    s_sub_u32 s47, s47, 1
    s_cbranch_scc1 L_s16x
    s_waitcnt lgkmcnt(0)
    v_cmp_gt_i32 vcc, 65, v5
    s_cbranch_vccnz L_s16
L_s16x:
    global_load_dwordx4 v[24:27], v6, s[26:27] offset:256 sc1
    global_load_dwordx4 v[32:35], v6, s[26:27] offset:384 sc1
    s_add_u32 s31, s31, 0x3b5d7f29
    v_mov_b32 v2, s31
    s_mov_b32 s47, 65536
    s_branch L_gbw
L_gb:
    s_sub_u32 s47, s47, 1
    s_cbranch_scc1 L_gbx
    s_mov_b64 exec, vcc
    global_load_dwordx4 v[24:27], v6, s[26:27] offset:256 sc1
    global_load_dwordx4 v[32:35], v6, s[26:27] offset:384 sc1
L_gbw:
    s_waitcnt vmcnt(0)
L_gbc:
    v_perm_b32 v22, v25, v24, s44
    v_perm_b32 v21, v27, v26, s45
    v_bitop3_b32 v4, v22, v21, v2 bitop3:0x56
    v_perm_b32 v22, v33, v32, s44
    v_perm_b32 v21, v35, v34, s45
    v_bitop3_b32 v22, v22, v21, v2 bitop3:0x56
    v_or_b32 v4, v4, v22
    v_cmp_lt_u32 vcc, 0, v4
    s_cbranch_vccnz L_gb
L_gbx:
    s_mov_b64 exec, -1
    v_and_b32 v24, s46, v24
    v_and_b32 v25, s46, v25
    v_and_b32 v26, s46, v26
    v_and_b32 v27, s46, v27
    v_and_b32 v32, s46, v32
    v_and_b32 v33, s46, v33
    v_and_b32 v34, s46, v34
    v_and_b32 v35, s46, v35
    v_add_f32_dpp v24, v24, v24 row_half_mirror row_mask:0xf bank_mask:0xf
    v_add_f32_dpp v25, v25, v25 row_half_mirror row_mask:0xf bank_mask:0xf
    v_add_f32_dpp v26, v26, v26 row_half_mirror row_mask:0xf bank_mask:0xf
    v_add_f32_dpp v27, v27, v27 row_half_mirror row_mask:0xf bank_mask:0xf
    v_add_f32_dpp v24, v32, v32 row_half_mirror row_mask:0xf bank_mask:0xa
    v_add_f32_dpp v25, v33, v33 row_half_mirror row_mask:0xf bank_mask:0xa
    v_add_f32_dpp v26, v34, v34 row_half_mirror row_mask:0xf bank_mask:0xa
    v_add_f32_dpp v27, v35, v35 row_half_mirror row_mask:0xf bank_mask:0xa
    v_add_f32_dpp v24, v24, v24 quad_perm:[1,0,3,2] row_mask:0xf bank_mask:0xf
    v_add_f32_dpp v25, v25, v25 quad_perm:[1,0,3,2] row_mask:0xf bank_mask:0xf
    v_add_f32_dpp v26, v26, v26 quad_perm:[1,0,3,2] row_mask:0xf bank_mask:0xf
    v_add_f32_dpp v27, v27, v27 quad_perm:[1,0,3,2] row_mask:0xf bank_mask:0xf
    v_add_f32_dpp v24, v24, v24 quad_perm:[2,3,0,1] row_mask:0xf bank_mask:0xf
    v_add_f32_dpp v25, v25, v25 quad_perm:[2,3,0,1] row_mask:0xf bank_mask:0xf
    v_add_f32_dpp v26, v26, v26 quad_perm:[2,3,0,1] row_mask:0xf bank_mask:0xf
    v_add_f32_dpp v27, v27, v27 quad_perm:[2,3,0,1] row_mask:0xf bank_mask:0xf
    v_cvt_pk_bf16_f32 v24, v24, v24
    v_and_b32 v24, s39, v24
    v_cvt_pk_bf16_f32 v25, v25, v25
    v_and_b32 v25, s39, v25
    v_cvt_pk_bf16_f32 v26, v26, v26
    v_and_b32 v26, s39, v26
    v_cvt_pk_bf16_f32 v27, v27, v27
    v_and_b32 v27, s39, v27
    s_mov_b32 s35, 0xbdd2d3e8
    v_mov_b32 v23, 0xc0135761
    v_mul_f32 v28, v24, v24
    v_mul_f32 v29, v25, v25
    v_fma_f32 v28, v28, s35, v23
    v_fma_f32 v29, v29, s35, v23
    v_mul_f32 v28, v28, v24
    v_mul_f32 v29, v29, v25
    v_exp_f32 v28, v28
    v_exp_f32 v29, v29
    v_add_f32 v28, 1.0, v28
    v_add_f32 v29, 1.0, v29
    v_rcp_f32 v28, v28
    v_rcp_f32 v29, v29
    v_mul_f32 v24, v24, v28
    v_mul_f32 v25, v25, v29
    v_cvt_pk_bf16_f32 v24, v24, v24
    v_and_b32 v24, s39, v24
    v_cvt_pk_bf16_f32 v25, v25, v25
    v_and_b32 v25, s39, v25
    v_mul_f32 v24, v24, v26
    v_mul_f32 v25, v25, v27
    v_cvt_pk_bf16_f32 v24, v24, v25
    v_mov_b32 v12, 1
    ds_write_b16 v7, v24 offset:64
    ds_write_b16_d16_hi v7, v24 offset:72
    ds_write_b32 v3, v12 offset:272
    s_endpgm
L_rs_1:
    s_mov_b64 exec, s[54:55]
    global_store_dwordx4 v35, v[180:183], s[26:27] offset:256 sc1
    s_mov_b64 exec, -1
    s_branch L_rs_1b
L_vhere:
    ds_read_b64_tr_b16 v[68:69], v6 offset:0
    ds_read_b64_tr_b16 v[70:71], v6 offset:4096
    ds_read_b64_tr_b16 v[72:73], v7 offset:0
    ds_read_b64_tr_b16 v[74:75], v7 offset:4096
    ds_read_b64_tr_b16 v[76:77], v6 offset:8192
    ds_read_b64_tr_b16 v[78:79], v6 offset:12288
    ds_read_b64_tr_b16 v[80:81], v7 offset:8192
    ds_read_b64_tr_b16 v[82:83], v7 offset:12288
    ds_read_b64_tr_b16 v[84:85], v6 offset:16384
    ds_read_b64_tr_b16 v[86:87], v6 offset:20480
    ds_read_b64_tr_b16 v[88:89], v7 offset:16384
    ds_read_b64_tr_b16 v[90:91], v7 offset:20480
    s_mov_b32 s47, 2097152
L_s9:
    ds_read_b32 v14, v10 offset:256
    ds_read_b128 v[44:47], v9 offset:3328
    ds_read_b128 v[48:51], v9 offset:3584
    ds_read_b128 v[52:55], v9 offset:3840
    ds_read_b128 v[56:59], v9 offset:4096
    s_sub_u32 s47, s47, 1
    s_cbranch_scc1 L_s9x
    s_waitcnt lgkmcnt(4)
    v_cmp_gt_i32 vcc, 6, v14
    s_cbranch_vccnz L_s9
L_s9x:
    ds_read_b64_tr_b16 v[92:93], v6 offset:24576
    ds_read_b64_tr_b16 v[94:95], v6 offset:28672
    ds_read_b64_tr_b16 v[96:97], v7 offset:24576
    ds_read_b64_tr_b16 v[98:99], v7 offset:28672
    s_waitcnt lgkmcnt(7)
    v_mfma_f32_16x16x32_bf16 v[148:151], v[192:195], v[44:47], 0
    s_waitcnt lgkmcnt(6)
    v_mfma_f32_16x16x32_bf16 v[148:151], v[192:195], v[48:51], v[148:151]
    s_waitcnt lgkmcnt(5)
    v_mfma_f32_16x16x32_bf16 v[148:151], v[192:195], v[52:55], v[148:151]
    s_waitcnt lgkmcnt(4)
    v_mfma_f32_16x16x32_bf16 v[148:151], v[192:195], v[56:59], v[148:151]
    v_mfma_f32_16x16x32_bf16 v[140:143], v[68:71], v[44:47], 0
    v_mfma_f32_16x16x32_bf16 v[144:147], v[72:75], v[44:47], 0
    v_mfma_f32_16x16x32_bf16 v[140:143], v[76:79], v[48:51], v[140:143]
    v_mfma_f32_16x16x32_bf16 v[144:147], v[80:83], v[48:51], v[144:147]
    v_mfma_f32_16x16x32_bf16 v[140:143], v[84:87], v[52:55], v[140:143]
    v_mfma_f32_16x16x32_bf16 v[144:147], v[88:91], v[52:55], v[144:147]
    s_nop 1
    v_log_f32 v126, v148
    v_rcp_f32 v17, v148
    v_mov_b32 v127, v4
    v_add_f32 v126, v126, v16
    s_branch L_vlast
L_rs_2:
    global_store_dwordx4 v8, v[124:127], s[26:27] offset:768 sc1
    s_branch L_rs_2b
L_last:
.fill (8192 - (L_last - L_pc)) / 4, 4, 0xbf800000
.section .rodata,"a"
.p2align 6
.amdhsa_kernel parallel_sum__sliding_block_cached__glu_gated_geglu__decode_kernel
  .amdhsa_next_free_vgpr 196
  .amdhsa_next_free_sgpr 96
  .amdhsa_accum_offset 196
  .amdhsa_group_segment_fixed_size 0
  .amdhsa_kernarg_size 96
  .amdhsa_user_sgpr_count 2
  .amdhsa_user_sgpr_kernarg_segment_ptr 1
  .amdhsa_system_sgpr_workgroup_id_x 1
.end_amdhsa_kernel
```
